```python
import torch

def _softmax(x, axis=-1):
    return torch.softmax(x, dim=axis)
def _gelu(x):
    return torch.nn.functional.gelu(x, approximate="tanh")
def _silu(x):
    return torch.nn.functional.silu(x)
def _sigmoid(x):
    return torch.sigmoid(x)
def _layernorm(x, axis=-1, eps=1e-5):
    m = x.mean(dim=axis, keepdim=True)
    v = x.var(dim=axis, keepdim=True, unbiased=False)
    return (x - m) / torch.sqrt(v + eps)
def _scatter_add(tgt, idx, src, axis=0):
    return tgt.clone().index_add_(axis, idx, src)
def _segment_sum(src, seg, n):
    out = torch.zeros((n,) + src.shape[1:], dtype=src.dtype)
    return out.index_add_(0, seg, src)
def _pad(x, pw):
    flat = tuple(v for pair in reversed(pw) for v in pair)
    return torch.nn.functional.pad(x, flat)

kernel_name = 'standalone__glu_gated_swiglu__decode'

def setup_inputs():

    _w = (lambda a: (lambda t: t.to(torch.bfloat16) if t.is_floating_point() else t)(torch.as_tensor(a)))
    B, S, D, F = 1, 1, 1024, 3584
    return {
        "x": _w((lambda *s: torch.randn(*s, dtype=torch.bfloat16) * 0.05)(B, S, D)),
        "w1": _w((lambda *s: torch.randn(*s, dtype=torch.bfloat16) * 0.05)(D, F) * (2.0 / D) ** 0.5),
        "w3": _w((lambda *s: torch.randn(*s, dtype=torch.bfloat16) * 0.05)(D, F) * (2.0 / D) ** 0.5),
        "w2": _w((lambda *s: torch.randn(*s, dtype=torch.bfloat16) * 0.05)(F, D) * (2.0 / F) ** 0.5),
    }

def reference(x, w1, w3, w2):
    gate = torch.einsum("bsd,df->bsf", x, w1)
    up = torch.einsum("bsd,df->bsf", x, w3)
    h = _silu(gate) * up
    out = torch.einsum("bsf,fd->bsd", h, w2)
    return out
```

```asm
; @launch grid=(256,1,1) block=(320,1,1) lds=6144
.amdgcn_target "amdgcn-amd-amdhsa--gfx950"
.text
.globl standalone__glu_gated_swiglu__decode_kernel
.p2align 8
.type standalone__glu_gated_swiglu__decode_kernel,@function
standalone__glu_gated_swiglu__decode_kernel:
s_load_dwordx8 s[4:11], s[0:1], 0
s_sub_u32 s2, s2, 32
s_cmpk_ge_u32 s2, 224
s_cbranch_scc1 L_helper
v_lshrrev_b32 v14, 4, v0
s_lshr_b32 s18, s2, 3
v_cmp_lt_u32 vcc, 15, v14
s_and_b32 s19, s2, 7
s_movk_i32 s35, 512
s_cmp_ge_u32 s18, 26
s_cmovk_i32 s35, -6656
s_cbranch_vccnz L_pub
v_lshl_add_u32 v14, s19, 4, v14
s_lshl_b32 s22, s18, 4
v_and_b32 v15, 15, v0
s_addk_i32 s22, 224
s_movk_i32 s24, 3584
v_add_u32 v2, s22, v15
v_lshlrev_b32 v1, 4, v14
v_mad_u32_u24 v2, v14, s24, v2
v_lshlrev_b32 v2, 4, v2
v_add_u32 v6, s35, v2
s_waitcnt lgkmcnt(0)
global_load_dwordx4 v[16:19], v1, s[4:5]
global_load_dwordx4 v[20:23], v2, s[6:7] offset:-3584 nt
global_load_dwordx4 v[52:55], v6, s[8:9] offset:-3584 nt
global_load_dwordx4 v[24:27], v2, s[6:7] offset:3584 nt
global_load_dwordx4 v[56:59], v6, s[8:9] offset:3584 nt
v_add_u32 v3, 14336, v2
v_add_u32 v7, s35, v3
s_load_dwordx2 s[16:17], s[0:1], 48
global_load_dwordx4 v[28:31], v3, s[6:7] offset:-3584 nt
global_load_dwordx4 v[60:63], v7, s[8:9] offset:-3584 nt
v_lshlrev_b32 v1, 4, v0
v_mov_b32 v164, 0xffff
v_mov_b32 v165, 0
v_and_b32 v10, 4, v0
v_lshlrev_b64 v[164:165], v1, v[164:165]
v_cmp_ne_u32 vcc, 0, v10
s_mov_b32 s30, 0x01000100
s_mov_b32 s31, 0x03020302
v_cndmask_b32 v166, 0, v164, vcc
v_cndmask_b32 v167, 0, v165, vcc
v_xor_b32 v164, v164, v166
v_xor_b32 v165, v165, v167
s_waitcnt vmcnt(6) lgkmcnt(0)
v_perm_b32 v136, v16, v16, s30
v_and_b32 v148, v136, v164
v_and_b32 v149, v136, v165
v_and_b32 v150, v136, v166
v_and_b32 v151, v136, v167
s_waitcnt vmcnt(5)
global_load_dwordx4 v[32:35], v3, s[6:7] offset:3584 nt
v_mfma_f32_16x16x32_bf16 v[116:119], v[148:151], v[20:23], 0
v_add_u32 v4, 28672, v2
v_add_u32 v8, s35, v4
s_load_dword s34, s[16:17], 0x61000
s_waitcnt vmcnt(5)
global_load_dwordx4 v[64:67], v7, s[8:9] offset:3584 nt
v_mfma_f32_16x16x32_bf16 v[120:123], v[148:151], v[52:55], 0
v_add_u32 v5, 43008, v2
v_add_u32 v9, s35, v5
v_readfirstlane_b32 s26, v0
v_bfe_u32 v13, v0, 4, 2
s_mov_b32 s37, 0
v_perm_b32 v136, v16, v16, s31
v_and_b32 v152, v136, v164
v_and_b32 v153, v136, v165
v_and_b32 v154, v136, v166
v_and_b32 v155, v136, v167
s_waitcnt vmcnt(5)
global_load_dwordx4 v[36:39], v4, s[6:7] offset:-3584 nt
v_mfma_f32_16x16x32_bf16 v[116:119], v[152:155], v[24:27], v[116:119]
s_waitcnt vmcnt(5)
global_load_dwordx4 v[68:71], v8, s[8:9] offset:-3584 nt
v_mfma_f32_16x16x32_bf16 v[120:123], v[152:155], v[56:59], v[120:123]
s_lshr_b32 s27, s26, 6
s_lshl_b32 s24, s18, 18
s_lshl_b32 s23, s19, 8
s_add_u32 s24, s24, s23
s_and_b32 s25, s27, 1
s_lshl_b32 s25, s25, 17
s_add_u32 s24, s24, s25
s_lshr_b32 s25, s27, 1
s_lshl_b32 s25, s25, 13
s_add_u32 s24, s24, s25
v_lshl_add_u32 v140, v15, 4, s24
v_lshl_add_u32 v140, v13, 11, v140
v_perm_b32 v136, v17, v17, s30
v_and_b32 v148, v136, v164
v_and_b32 v149, v136, v165
v_and_b32 v150, v136, v166
v_and_b32 v151, v136, v167
s_waitcnt vmcnt(5)
global_load_dwordx4 v[40:43], v4, s[6:7] offset:3584 nt
v_mfma_f32_16x16x32_bf16 v[116:119], v[148:151], v[28:31], v[116:119]
s_waitcnt vmcnt(5)
global_load_dwordx4 v[72:75], v8, s[8:9] offset:3584 nt
v_mfma_f32_16x16x32_bf16 v[120:123], v[148:151], v[60:63], v[120:123]
v_add_u32 v141, 16384, v140
v_add_u32 v142, 32768, v140
v_add_u32 v143, 49152, v140
v_add_u32 v144, 65536, v140
v_add_u32 v145, 81920, v140
v_add_u32 v146, 98304, v140
v_add_u32 v147, 114688, v140
v_perm_b32 v136, v17, v17, s31
v_and_b32 v152, v136, v164
v_and_b32 v153, v136, v165
v_and_b32 v154, v136, v166
v_and_b32 v155, v136, v167
s_waitcnt vmcnt(5)
global_load_dwordx4 v[44:47], v5, s[6:7] offset:-3584 nt
v_mfma_f32_16x16x32_bf16 v[116:119], v[152:155], v[32:35], v[116:119]
s_waitcnt vmcnt(5)
global_load_dwordx4 v[76:79], v9, s[8:9] offset:-3584 nt
v_mfma_f32_16x16x32_bf16 v[120:123], v[152:155], v[64:67], v[120:123]
v_lshlrev_b32 v124, 4, v0
v_bfe_u32 v127, v0, 3, 3
v_and_b32 v126, 7, v0
s_lshl_b32 s24, s27, 7
s_lshl_b32 s25, s18, 13
s_add_u32 s24, s24, s25
v_lshl_add_u32 v126, v126, 4, s24
v_lshl_add_u32 v125, v127, 10, v126
v_perm_b32 v136, v18, v18, s30
v_and_b32 v148, v136, v164
v_and_b32 v149, v136, v165
v_and_b32 v150, v136, v166
v_and_b32 v151, v136, v167
s_waitcnt vmcnt(5)
global_load_dwordx4 v[48:51], v5, s[6:7] offset:3584 nt
v_mfma_f32_16x16x32_bf16 v[116:119], v[148:151], v[36:39], v[116:119]
s_waitcnt vmcnt(5)
global_load_dwordx4 v[80:83], v9, s[8:9] offset:3584 nt
v_mfma_f32_16x16x32_bf16 v[120:123], v[148:151], v[68:71], v[120:123]
s_lshl_b32 s24, s27, 9
v_lshl_add_u32 v126, v15, 5, s24
v_lshl_add_u32 v126, v13, 4, v126
s_waitcnt lgkmcnt(0)
s_add_u32 s72, s34, 1
s_add_u32 s73, s34, 2
s_add_u32 s74, s34, 3
s_add_u32 s75, s34, 4
s_and_b32 s72, s72, 15
s_and_b32 s73, s73, 15
s_and_b32 s74, s74, 15
s_and_b32 s75, s75, 15
v_perm_b32 v136, v18, v18, s31
v_and_b32 v152, v136, v164
v_and_b32 v153, v136, v165
v_and_b32 v154, v136, v166
v_and_b32 v155, v136, v167
s_waitcnt vmcnt(5)
s_nop 0
v_mfma_f32_16x16x32_bf16 v[116:119], v[152:155], v[40:43], v[116:119]
s_waitcnt vmcnt(4)
global_load_dwordx4 v[84:87], v140, s[10:11] nt
v_mfma_f32_16x16x32_bf16 v[120:123], v[152:155], v[72:75], v[120:123]
v_perm_b32 v136, v19, v19, s30
v_and_b32 v148, v136, v164
v_and_b32 v149, v136, v165
v_and_b32 v150, v136, v166
v_and_b32 v151, v136, v167
s_waitcnt vmcnt(4)
global_load_dwordx4 v[88:91], v141, s[10:11] nt
v_mfma_f32_16x16x32_bf16 v[116:119], v[148:151], v[44:47], v[116:119]
s_waitcnt vmcnt(4)
global_load_dwordx4 v[92:95], v142, s[10:11] nt
v_mfma_f32_16x16x32_bf16 v[120:123], v[148:151], v[76:79], v[120:123]
v_perm_b32 v136, v19, v19, s31
v_and_b32 v152, v136, v164
v_and_b32 v153, v136, v165
v_and_b32 v154, v136, v166
v_and_b32 v155, v136, v167
s_waitcnt vmcnt(4)
global_load_dwordx4 v[96:99], v143, s[10:11] nt
v_mfma_f32_16x16x32_bf16 v[116:119], v[152:155], v[48:51], v[116:119]
s_waitcnt vmcnt(4)
global_load_dwordx4 v[100:103], v144, s[10:11] nt
v_mfma_f32_16x16x32_bf16 v[120:123], v[152:155], v[80:83], v[120:123]
s_mov_b32 exec_hi, 0
s_nop 5
ds_write_b128 v124, v[116:119]
s_not_b64 exec, exec
ds_write_b128 v124, v[120:123]
s_mov_b64 exec, -1
s_waitcnt lgkmcnt(0)
s_barrier
s_barrier
global_load_dwordx4 v[104:107], v145, s[10:11] nt
s_waitcnt vmcnt(5)
global_load_dwordx4 v[108:111], v146, s[10:11] nt
s_waitcnt vmcnt(5)
global_load_dwordx4 v[112:115], v147, s[10:11] nt
s_waitcnt vmcnt(1)
L_retry:
global_load_dwordx4 v[156:159], v125, s[16:17] sc1
global_load_dwordx4 v[160:163], v125, s[16:17] offset:512 sc1
s_add_u32 s37, s37, 1
s_cmp_gt_u32 s37, 4000000
s_cbranch_scc1 L_got
L_poll:
s_waitcnt vmcnt(1)
v_xor_b32 v132, s72, v156
v_xor_b32 v133, s73, v157
v_xor_b32 v134, s74, v158
v_xor_b32 v135, s75, v159
v_or3_b32 v8, v132, v133, v134
s_waitcnt vmcnt(0)
v_xor_b32 v136, s72, v160
v_xor_b32 v137, s73, v161
v_xor_b32 v138, s74, v162
v_xor_b32 v139, s75, v163
v_or3_b32 v8, v8, v135, v136
v_or3_b32 v8, v8, v137, v138
v_bitop3_b32 v8, v8, v139, 15 bitop3:0xa8
v_cmp_ne_u32 vcc, 0, v8
s_cbranch_vccnz L_retry
L_got:
v_permlane32_swap_b32 v132, v134
v_permlane32_swap_b32 v133, v135
v_permlane32_swap_b32 v136, v138
v_permlane32_swap_b32 v137, v139
v_pk_add_f32 v[132:133], v[132:133], v[134:135]
v_pk_add_f32 v[136:137], v[136:137], v[138:139]
s_nop 0
v_permlane16_swap_b32 v132, v133
v_permlane16_swap_b32 v136, v137
v_add_f32 v132, v132, v133
v_add_f32 v136, v136, v137
s_nop 0
v_add_f32_dpp v132, v132, v132 row_ror:8 row_mask:0xf bank_mask:0xf
v_add_f32_dpp v136, v136, v136 row_ror:8 row_mask:0xf bank_mask:0xf
v_cvt_pk_bf16_f32 v133, 0, v132
v_mul_f32 v135, 0xbfb8aa3b, v133
v_exp_f32 v135, v135
v_cvt_pk_bf16_f32 v134, 0, v136
v_add_f32 v135, 1.0, v135
v_rcp_f32 v135, v135
s_nop 0
v_mul_f32 v133, v133, v135
v_cvt_pk_bf16_f32 v133, 0, v133
v_mul_f32 v133, v133, v134
v_cvt_pk_bf16_f32 v133, v133, v133
s_nop 1
v_and_b32_dpp v20, v133, v164 row_newbcast:0 row_mask:0xf bank_mask:0xf
v_and_b32_dpp v21, v133, v165 row_newbcast:0 row_mask:0xf bank_mask:0xf
v_and_b32_dpp v22, v133, v166 row_newbcast:0 row_mask:0xf bank_mask:0xf
v_and_b32_dpp v23, v133, v167 row_newbcast:0 row_mask:0xf bank_mask:0xf
v_and_b32_dpp v24, v133, v164 row_newbcast:1 row_mask:0xf bank_mask:0xf
v_and_b32_dpp v25, v133, v165 row_newbcast:1 row_mask:0xf bank_mask:0xf
v_and_b32_dpp v26, v133, v166 row_newbcast:1 row_mask:0xf bank_mask:0xf
v_and_b32_dpp v27, v133, v167 row_newbcast:1 row_mask:0xf bank_mask:0xf
v_mfma_f32_16x16x32_bf16 v[116:119], v[20:23], v[84:87], 0
v_and_b32_dpp v28, v133, v164 row_newbcast:2 row_mask:0xf bank_mask:0xf
v_and_b32_dpp v29, v133, v165 row_newbcast:2 row_mask:0xf bank_mask:0xf
v_and_b32_dpp v30, v133, v166 row_newbcast:2 row_mask:0xf bank_mask:0xf
v_and_b32_dpp v31, v133, v167 row_newbcast:2 row_mask:0xf bank_mask:0xf
v_mfma_f32_16x16x32_bf16 v[116:119], v[24:27], v[88:91], v[116:119]
v_and_b32_dpp v32, v133, v164 row_newbcast:3 row_mask:0xf bank_mask:0xf
v_and_b32_dpp v33, v133, v165 row_newbcast:3 row_mask:0xf bank_mask:0xf
v_and_b32_dpp v34, v133, v166 row_newbcast:3 row_mask:0xf bank_mask:0xf
v_and_b32_dpp v35, v133, v167 row_newbcast:3 row_mask:0xf bank_mask:0xf
v_mfma_f32_16x16x32_bf16 v[116:119], v[28:31], v[92:95], v[116:119]
v_and_b32_dpp v36, v133, v164 row_newbcast:4 row_mask:0xf bank_mask:0xf
v_and_b32_dpp v37, v133, v165 row_newbcast:4 row_mask:0xf bank_mask:0xf
v_and_b32_dpp v38, v133, v166 row_newbcast:4 row_mask:0xf bank_mask:0xf
v_and_b32_dpp v39, v133, v167 row_newbcast:4 row_mask:0xf bank_mask:0xf
v_mfma_f32_16x16x32_bf16 v[116:119], v[32:35], v[96:99], v[116:119]
v_and_b32_dpp v40, v133, v164 row_newbcast:5 row_mask:0xf bank_mask:0xf
v_and_b32_dpp v41, v133, v165 row_newbcast:5 row_mask:0xf bank_mask:0xf
v_and_b32_dpp v42, v133, v166 row_newbcast:5 row_mask:0xf bank_mask:0xf
v_and_b32_dpp v43, v133, v167 row_newbcast:5 row_mask:0xf bank_mask:0xf
v_mfma_f32_16x16x32_bf16 v[116:119], v[36:39], v[100:103], v[116:119]
v_and_b32_dpp v44, v133, v164 row_newbcast:6 row_mask:0xf bank_mask:0xf
v_and_b32_dpp v45, v133, v165 row_newbcast:6 row_mask:0xf bank_mask:0xf
v_and_b32_dpp v46, v133, v166 row_newbcast:6 row_mask:0xf bank_mask:0xf
v_and_b32_dpp v47, v133, v167 row_newbcast:6 row_mask:0xf bank_mask:0xf
v_mfma_f32_16x16x32_bf16 v[116:119], v[40:43], v[104:107], v[116:119]
v_and_b32_dpp v48, v133, v164 row_newbcast:7 row_mask:0xf bank_mask:0xf
v_and_b32_dpp v49, v133, v165 row_newbcast:7 row_mask:0xf bank_mask:0xf
v_and_b32_dpp v50, v133, v166 row_newbcast:7 row_mask:0xf bank_mask:0xf
v_and_b32_dpp v51, v133, v167 row_newbcast:7 row_mask:0xf bank_mask:0xf
v_mfma_f32_16x16x32_bf16 v[116:119], v[44:47], v[108:111], v[116:119]
s_nop 0
v_mfma_f32_16x16x32_bf16 v[116:119], v[48:51], v[112:115], v[116:119]
s_mov_b32 exec_hi, 0
s_nop 6
ds_write_b128 v126, v[116:119] offset:4096
s_waitcnt lgkmcnt(0)
s_barrier
s_endpgm
L_pub:
s_load_dwordx2 s[16:17], s[0:1], 48
v_and_b32 v3, 63, v0
v_lshlrev_b32 v3, 4, v3
s_lshl_b32 s24, s2, 10
v_add_u32 v4, s24, v3
s_lshl_b32 s35, s35, 5
v_bfe_u32 v5, v0, 5, 1
v_mul_lo_u32 v5, v5, s35
v_add_u32 v4, v4, v5
s_mul_i32 s24, s19, 28
s_add_u32 s24, s24, s18
s_lshl_b32 s24, s24, 9
s_add_u32 s24, s24, 0x40000
v_add_u32 v7, s24, v3
s_waitcnt lgkmcnt(0)
s_load_dword s34, s[16:17], 0x61000
s_getreg_b32 s22, hwreg(HW_REG_XCC_ID, 0, 4)
v_and_b32 v10, 15, v0
s_lshl_b32 s24, s19, 7
s_add_u32 s24, s24, 0x60000
v_lshl_add_u32 v10, v10, 2, s24
s_lshl_b32 s22, s22, 8
s_waitcnt lgkmcnt(0)
s_add_u32 s72, s34, 1
s_add_u32 s73, s34, 2
s_add_u32 s74, s34, 3
s_add_u32 s75, s34, 4
s_and_b32 s72, s72, 15
s_and_b32 s73, s73, 15
s_and_b32 s74, s74, 15
s_and_b32 s75, s75, 15
v_add_u32 v12, s72, v0
v_and_b32 v12, 15, v12
v_or_b32 v12, s22, v12
s_setprio 3
s_mov_b64 exec, -1
s_barrier
ds_read_b128 v[16:19], v3 offset:0
ds_read_b128 v[20:23], v3 offset:1024
ds_read_b128 v[24:27], v3 offset:2048
ds_read_b128 v[28:31], v3 offset:3072
s_waitcnt lgkmcnt(2)
v_pk_add_f32 v[16:17], v[16:17], v[20:21]
v_pk_add_f32 v[18:19], v[18:19], v[22:23]
s_waitcnt lgkmcnt(0)
v_pk_add_f32 v[24:25], v[24:25], v[28:29]
v_pk_add_f32 v[26:27], v[26:27], v[30:31]
v_pk_add_f32 v[16:17], v[16:17], v[24:25]
v_pk_add_f32 v[18:19], v[18:19], v[26:27]
v_bfi_b32 v16, 15, s72, v16
v_bfi_b32 v17, 15, s73, v17
v_bfi_b32 v18, 15, s74, v18
v_bfi_b32 v19, 15, s75, v19
global_store_dwordx4 v4, v[16:19], s[16:17] sc1
s_barrier
global_load_dword v11, v10, s[16:17] sc1
s_waitcnt vmcnt(0)
v_cmp_ne_u32 vcc, v12, v11
v_lshrrev_b32 v5, 1, v3
v_sub_u32 v7, v7, v5
v_add_u32 v5, 4096, v5
v_and_b32 v8, 1, v0
v_lshl_add_u32 v8, v8, 1, s72
v_add_u32 v9, 1, v8
s_barrier
ds_read2_b64 v[32:35], v5 offset0:0 offset1:64
ds_read2_b64 v[36:39], v5 offset0:128 offset1:192
s_waitcnt lgkmcnt(1)
v_pk_add_f32 v[32:33], v[32:33], v[34:35]
s_waitcnt lgkmcnt(0)
v_pk_add_f32 v[36:37], v[36:37], v[38:39]
v_pk_add_f32 v[32:33], v[32:33], v[36:37]
v_bfi_b32 v32, 15, v8, v32
v_bfi_b32 v33, 15, v9, v33
s_cbranch_vccnz L_qloc
global_store_dwordx2 v7, v[32:33], s[16:17]
s_endpgm
L_qloc:
global_store_dwordx2 v7, v[32:33], s[16:17] sc1
L_qdone:
s_endpgm
L_helper:
s_load_dwordx2 s[12:13], s[0:1], 32
s_load_dwordx2 s[16:17], s[0:1], 48
s_mov_b32 s37, 0
s_add_u32 s18, s2, 32
s_cmp_ge_u32 s18, 32
s_cbranch_scc1 L_end
v_readfirstlane_b32 s26, v0
s_and_b32 s20, s18, 7
s_lshr_b32 s21, s18, 3
s_cmp_lg_u32 s26, 0
s_cbranch_scc1 L_end
s_waitcnt lgkmcnt(0)
s_load_dword s34, s[16:17], 0x61000
s_getreg_b32 s23, hwreg(HW_REG_XCC_ID, 0, 4)
s_mul_i32 s24, s20, 14336
s_lshl_b32 s25, s21, 7
s_add_u32 s24, s24, s25
s_add_u32 s24, s24, 0x41000
v_and_b32 v4, 7, v0
v_lshl_add_u32 v2, v4, 4, s24
v_lshrrev_b32 v3, 3, v0
v_lshl_add_u32 v2, v3, 9, v2
v_add_u32 v3, 8192, v2
s_lshl_b32 s24, s20, 8
s_lshl_b32 s25, s21, 6
s_add_u32 s24, s24, s25
v_lshrrev_b32 v7, 5, v0
v_lshl_add_u32 v7, v7, 2, s24
v_lshl_add_u32 v7, v4, 3, v7
s_lshl_b32 s24, s20, 7
s_lshl_b32 s25, s21, 4
s_add_u32 s24, s24, s25
s_add_u32 s24, s24, 0x60000
v_lshl_add_u32 v5, v0, 2, s24
s_lshl_b32 s23, s23, 8
v_lshrrev_b32 v10, 3, v0
v_lshlrev_b32 v10, 7, v10
v_lshl_add_u32 v10, v4, 3, v10
v_add_u32 v10, 0x60000, v10
s_waitcnt lgkmcnt(0)
s_add_u32 s72, s34, 1
s_add_u32 s73, s34, 2
s_add_u32 s74, s34, 3
s_add_u32 s75, s34, 4
s_and_b32 s72, s72, 15
s_and_b32 s73, s73, 15
s_and_b32 s74, s74, 15
s_and_b32 s75, s75, 15
s_lshl_b32 s25, s21, 2
s_add_u32 s25, s25, s72
v_add_u32 v6, s25, v0
v_and_b32 v6, 15, v6
v_or_b32 v6, s23, v6
v_mov_b32 v40, s72
v_mov_b32 v41, s73
v_mov_b32 v42, s74
v_mov_b32 v43, s75
v_mov_b32 v56, s72
v_mov_b32 v57, s73
v_mov_b32 v58, s74
v_mov_b32 v59, s75
s_mov_b64 exec, 15
global_store_dword v5, v6, s[16:17] sc1
s_mov_b64 exec, -1
s_cmp_lg_u32 s18, 0
s_cbranch_scc1 L_hgo
v_lshl_add_u32 v6, v0, 1, s72
v_add_u32 v11, 1, v6
v_and_b32 v6, 15, v6
v_and_b32 v11, 15, v11
L_gchk:
s_add_u32 s37, s37, 1
s_cmp_gt_u32 s37, 4000000
s_cbranch_scc1 L_hgo
global_load_dwordx2 v[12:13], v10, s[16:17] sc1
s_waitcnt vmcnt(0)
v_xor_b32 v12, v6, v12
v_xor_b32 v13, v11, v13
v_or_b32 v8, v12, v13
v_and_b32 v8, 0xfffff0ff, v8
v_cmp_ne_u32 vcc, 0, v8
s_cbranch_vccnz L_gchk
L_hgo:
global_load_dwordx4 v[28:31], v2, s[16:17] offset:-4096 sc1
global_load_dwordx4 v[32:35], v2, s[16:17] sc1
global_load_dwordx4 v[36:39], v3, s[16:17] offset:-4096 sc1
s_mov_b32 exec_hi, 0
global_load_dwordx4 v[40:43], v3, s[16:17] sc1
s_mov_b32 exec_hi, -1
L_hpoll:
s_add_u32 s37, s37, 1
s_cmp_gt_u32 s37, 4000000
s_cbranch_scc1 L_hgot
global_load_dwordx4 v[44:47], v2, s[16:17] offset:-4096 sc1
global_load_dwordx4 v[48:51], v2, s[16:17] sc1
global_load_dwordx4 v[52:55], v3, s[16:17] offset:-4096 sc1
s_mov_b32 exec_hi, 0
global_load_dwordx4 v[56:59], v3, s[16:17] sc1
s_mov_b32 exec_hi, -1
s_waitcnt vmcnt(7)
v_xor_b32 v12, s72, v28
v_xor_b32 v13, s73, v29
v_xor_b32 v14, s74, v30
v_xor_b32 v15, s75, v31
v_or3_b32 v8, v12, v13, v14
s_waitcnt vmcnt(6)
v_xor_b32 v16, s72, v32
v_xor_b32 v17, s73, v33
v_xor_b32 v18, s74, v34
v_xor_b32 v19, s75, v35
v_or3_b32 v8, v8, v15, v16
v_or3_b32 v8, v8, v17, v18
s_waitcnt vmcnt(5)
v_xor_b32 v20, s72, v36
v_xor_b32 v21, s73, v37
v_xor_b32 v22, s74, v38
v_xor_b32 v23, s75, v39
v_or3_b32 v8, v8, v19, v20
v_or3_b32 v8, v8, v21, v22
s_waitcnt vmcnt(4)
v_xor_b32 v24, s72, v40
v_xor_b32 v25, s73, v41
v_xor_b32 v26, s74, v42
v_xor_b32 v27, s75, v43
v_or3_b32 v8, v8, v23, v24
v_or3_b32 v8, v8, v25, v26
v_bitop3_b32 v8, v8, v27, 15 bitop3:0xa8
v_cmp_ne_u32 vcc, 0, v8
s_cbranch_vccz L_hgot
global_load_dwordx4 v[28:31], v2, s[16:17] offset:-4096 sc1
global_load_dwordx4 v[32:35], v2, s[16:17] sc1
global_load_dwordx4 v[36:39], v3, s[16:17] offset:-4096 sc1
s_mov_b32 exec_hi, 0
global_load_dwordx4 v[40:43], v3, s[16:17] sc1
s_mov_b32 exec_hi, -1
s_waitcnt vmcnt(7)
v_xor_b32 v12, s72, v44
v_xor_b32 v13, s73, v45
v_xor_b32 v14, s74, v46
v_xor_b32 v15, s75, v47
v_or3_b32 v8, v12, v13, v14
s_waitcnt vmcnt(6)
v_xor_b32 v16, s72, v48
v_xor_b32 v17, s73, v49
v_xor_b32 v18, s74, v50
v_xor_b32 v19, s75, v51
v_or3_b32 v8, v8, v15, v16
v_or3_b32 v8, v8, v17, v18
s_waitcnt vmcnt(5)
v_xor_b32 v20, s72, v52
v_xor_b32 v21, s73, v53
v_xor_b32 v22, s74, v54
v_xor_b32 v23, s75, v55
v_or3_b32 v8, v8, v19, v20
v_or3_b32 v8, v8, v21, v22
s_waitcnt vmcnt(4)
v_xor_b32 v24, s72, v56
v_xor_b32 v25, s73, v57
v_xor_b32 v26, s74, v58
v_xor_b32 v27, s75, v59
v_or3_b32 v8, v8, v23, v24
v_or3_b32 v8, v8, v25, v26
v_bitop3_b32 v8, v8, v27, 15 bitop3:0xa8
v_cmp_ne_u32 vcc, 0, v8
s_cbranch_vccnz L_hpoll
L_hgot:
v_pk_add_f32 v[12:13], v[12:13], v[16:17]
v_pk_add_f32 v[14:15], v[14:15], v[18:19]
v_pk_add_f32 v[20:21], v[20:21], v[24:25]
v_pk_add_f32 v[22:23], v[22:23], v[26:27]
v_pk_add_f32 v[12:13], v[12:13], v[20:21]
v_pk_add_f32 v[14:15], v[14:15], v[22:23]
s_nop 1
v_permlane32_swap_b32 v12, v14
v_permlane32_swap_b32 v13, v15
v_pk_add_f32 v[12:13], v[12:13], v[14:15]
v_mov_b32 v14, v12
v_mov_b32 v15, v13
s_nop 0
v_permlane16_swap_b32 v12, v14
v_permlane16_swap_b32 v13, v15
v_pk_add_f32 v[12:13], v[12:13], v[14:15]
s_nop 1
v_add_f32_dpp v12, v12, v12 row_ror:8 row_mask:0xf bank_mask:0xf
v_add_f32_dpp v13, v13, v13 row_ror:8 row_mask:0xf bank_mask:0xf
s_mov_b32 exec_lo, 0xff
s_mov_b32 exec_hi, 0xff
v_cvt_pk_bf16_f32 v12, v12, v13
global_store_dword v7, v12, s[12:13]
s_cmp_lg_u32 s18, 0
s_cbranch_scc1 L_noe
s_mov_b32 exec_lo, -1
s_mov_b32 exec_hi, 0
v_lshlrev_b32 v5, 2, v0
v_add_u32 v5, 0x61000, v5
v_mov_b32 v6, s72
global_store_dword v5, v6, s[16:17]
L_noe:
L_end:
s_endpgm
.section .rodata,"a"
.p2align 6
.amdhsa_kernel standalone__glu_gated_swiglu__decode_kernel
  .amdhsa_next_free_vgpr 168
  .amdhsa_next_free_sgpr 80
  .amdhsa_accum_offset 168
  .amdhsa_group_segment_fixed_size 0
  .amdhsa_kernarg_size 56
  .amdhsa_user_sgpr_count 2
  .amdhsa_user_sgpr_kernarg_segment_ptr 1
  .amdhsa_system_sgpr_workgroup_id_x 1
.end_amdhsa_kernel
```
